```python
import torch

def _softmax(x, axis=-1):
    return torch.softmax(x, dim=axis)
def _gelu(x):
    return torch.nn.functional.gelu(x, approximate="tanh")
def _silu(x):
    return torch.nn.functional.silu(x)
def _sigmoid(x):
    return torch.sigmoid(x)
def _layernorm(x, axis=-1, eps=1e-5):
    m = x.mean(dim=axis, keepdim=True)
    v = x.var(dim=axis, keepdim=True, unbiased=False)
    return (x - m) / torch.sqrt(v + eps)
def _scatter_add(tgt, idx, src, axis=0):
    return tgt.clone().index_add_(axis, idx, src)
def _segment_sum(src, seg, n):
    out = torch.zeros((n,) + src.shape[1:], dtype=src.dtype)
    return out.index_add_(0, seg, src)
def _pad(x, pw):
    flat = tuple(v for pair in reversed(pw) for v in pair)
    return torch.nn.functional.pad(x, flat)

kernel_name = 'standalone__gqa_softmax__decode'

def setup_inputs():

    _w = (lambda a: (lambda t: t.to(torch.bfloat16) if t.is_floating_point() else t)(torch.as_tensor(a)))
    B, Hq, Hkv, Sq, Sk, D = 8, 32, 8, 1, 8192, 128
    return {
        "q": _w((lambda *s: torch.randn(*s, dtype=torch.bfloat16) * 0.8)(B, Hq, Sq, D)),
        "k": _w((lambda *s: torch.randn(*s, dtype=torch.bfloat16) * 0.8)(B, Hkv, Sk, D)),
        "v": _w((lambda *s: torch.randn(*s, dtype=torch.bfloat16) * 0.05)(B, Hkv, Sk, D)),
    }

def reference(q, k, v):
    B, Hq, Sq, D = q.shape
    Hkv = k.shape[1]
    rep = Hq // Hkv
    k = (lambda x, n, axis: torch.repeat_interleave(x, n, dim=axis))(k, rep, axis=1)
    v = (lambda x, n, axis: torch.repeat_interleave(x, n, dim=axis))(v, rep, axis=1)
    scale = D ** -0.5
    scores = torch.einsum("bhqd,bhkd->bhqk", q, k) * scale
    p = _softmax(scores, axis=-1)
    return torch.einsum("bhqk,bhkd->bhqd", p, v)
```

```asm
; @launch grid=(256,1,1) block=(320,1,1) lds=107520
.amdgcn_target "amdgcn-amd-amdhsa--gfx950"
.text
.globl standalone__gqa_softmax__decode_kernel
.p2align 8
.type standalone__gqa_softmax__decode_kernel,@function
standalone__gqa_softmax__decode_kernel:
    s_load_dwordx8 s[4:11], s[0:1], 0
    s_load_dwordx4 s[12:15], s[0:1], 32
    s_cmp_ge_u32 s2, 256
    s_cbranch_scc1 L_done
    v_lshrrev_b32 v16, 6, v0
    v_and_b32 v10, 63, v0
    s_lshr_b32 s40, s2, 3
    v_readfirstlane_b32 s42, v16
    s_lshl_b32 s40, s40, 1
    s_bfe_u32 s44, s2, 0x10001
    s_or_b32 s40, s40, s44
    s_bfe_u32 s44, s2, 0x10002
    s_lshl_b32 s44, s44, 1
    s_and_b32 s41, s2, 1
    s_or_b32 s41, s41, s44
    v_lshlrev_b32 v19, 4, v10
    v_lshlrev_b32 v87, 2, v10
    s_mul_i32 s55, s40, 20480
    s_cmp_lg_u32 s42, 4
    s_cbranch_scc1 L_worker
    s_barrier
    s_branch L_helper
L_worker:
    v_bfe_u32 v17, v0, 4, 2
    v_and_b32 v9, 0xf0, v19
    v_lshl_add_u32 v9, v16, 8, v9
    v_lshl_add_u32 v9, v17, 12, v9
    v_lshlrev_b32 v16, 6, v17
    v_xor_b32 v1, v9, v16
    v_xor_b32 v2, 16, v1
    v_xor_b32 v3, 32, v1
    v_xor_b32 v4, 48, v1
    s_mov_b32 s18, 0x200000
    s_mov_b32 s19, 0x00020000
    s_mov_b32 s22, 0x200000
    s_mov_b32 s23, 0x00020000
    s_mov_b32 s26, 1024
    s_mov_b32 s27, 0x00020000
    s_lshl_b32 s44, s40, 21
    s_lshl_b32 s45, s40, 10
    s_lshl_b32 s48, s41, 14
    s_lshl_b32 s47, s42, 14
    s_add_u32 s47, s47, 41984
    s_lshl_b32 s49, s42, 11
    s_add_u32 s49, s49, 1024
    s_mov_b32 m0, s49
    s_mov_b64 exec, 0
    s_cmp_eq_u32 s42, 0
    s_cbranch_scc1 L_e0
    s_cmp_eq_u32 s42, 1
    s_cbranch_scc1 L_e1
    s_cmp_eq_u32 s42, 2
    s_cbranch_scc1 L_e2
    s_cmp_eq_u32 s42, 3
    s_cbranch_scc1 L_e3
L_eback:
    s_mov_b64 exec, -1
    s_waitcnt lgkmcnt(0)
    s_add_u32 s24, s4, s45
    s_addc_u32 s25, s5, 0
    s_add_u32 s16, s6, s44
    s_addc_u32 s17, s7, 0
    buffer_load_dwordx4 v19, s[24:27], 0 offen  lds
    s_mov_b32 m0, s47
    s_add_u32 s20, s8, s44
    s_addc_u32 s21, s9, 0
    buffer_load_dwordx4 v1, s[16:19], s48 offen offset:0 nt lds
    buffer_load_dwordx4 v2, s[16:19], s48 offen offset:1024 nt lds
    buffer_load_dwordx4 v3, s[16:19], s48 offen offset:2048 nt lds
    buffer_load_dwordx4 v4, s[16:19], s48 offen offset:3072 nt lds
    s_add_u32 s48, s48, 65536
    s_add_u32 m0, s47, 4096
    s_nop 0
    buffer_load_dwordx4 v1, s[16:19], s48 offen offset:0 nt lds
    buffer_load_dwordx4 v2, s[16:19], s48 offen offset:1024 nt lds
    buffer_load_dwordx4 v3, s[16:19], s48 offen offset:2048 nt lds
    buffer_load_dwordx4 v4, s[16:19], s48 offen offset:3072 nt lds
L_e0:
    s_cbranch_execz L_eback
    s_add_u32 s28, s14, s55
    s_addc_u32 s29, s15, 0
    s_mov_b32 s30, 16384
    s_mov_b32 s31, 0x00020000
    s_add_u32 s36, s28, 16384
    s_addc_u32 s37, s29, 0
    s_mov_b32 s38, 4
    s_mov_b32 s39, 0x00020000
    s_add_u32 s32, s10, s45
    s_addc_u32 s33, s11, 0
    s_mov_b32 s34, 1024
    s_mov_b32 s35, 0x00020000
    s_add_u32 s50, s41, 0
    s_and_b32 s50, s50, 3
    s_lshl_b32 s50, s50, 12
    s_add_u32 s51, s41, 1
    s_and_b32 s51, s51, 3
    s_lshl_b32 s51, s51, 12
    s_add_u32 s52, s41, 2
    s_and_b32 s52, s52, 3
    s_lshl_b32 s52, s52, 12
    s_add_u32 s53, s41, 3
    s_and_b32 s53, s53, 3
    s_lshl_b32 s53, s53, 12
    s_mov_b32 s43, 0x3e0293ee
    v_and_b32 v15, 3, v0
    v_lshlrev_b32 v18, 8, v15
    v_lshl_add_u32 v18, v17, 4, v18
    v_add_u32 v18, s49, v18
    s_lshl_b32 s44, s42, 13
    s_add_u32 s44, s44, 9216
    v_lshl_add_u32 v84, v17, 2, v15
    v_lshl_add_u32 v84, v84, 4, s44
    v_mov_b32 v86, v84
    v_and_b32 v16, 15, v0
    v_xor_b32 v5, v17, v16
    v_lshlrev_b32 v5, 4, v5
    v_lshl_add_u32 v5, v15, 10, v5
    v_bfe_u32 v17, v0, 2, 2
    v_lshl_add_u32 v5, v17, 8, v5
    v_add_u32 v5, s47, v5
    v_xor_b32 v6, 64, v5
    v_xor_b32 v7, 128, v5
    v_xor_b32 v8, 192, v5
L_e1:
    s_cbranch_execz L_eback
    v_add_u32 v185, s41, v17
    v_and_b32 v185, 3, v185
    v_lshlrev_b32 v185, 12, v185
    v_lshl_add_u32 v185, v15, 4, v185
    v_lshlrev_b32 v85, 5, v17
    v_lshl_add_u32 v85, v15, 2, v85
    s_lshl_b32 s44, s42, 5
    v_lshl_add_u32 v10, v15, 2, s44
    v_and_b32 v16, 1, v17
    v_lshlrev_b32 v16, 4, v16
    v_mov_b32 v12, 0xffff
    v_lshlrev_b32 v16, v16, v12
    v_cmp_gt_u32 vcc, 2, v17
    v_mov_b32 v48, 0x3f803f80
    v_mov_b32 v49, 0x3f803f80
    v_mov_b32 v50, 0x3f803f80
    v_mov_b32 v51, 0x3f803f80
    v_cndmask_b32 v11, 0, v16, vcc
    v_cndmask_b32 v12, v16, 0, vcc
    v_mov_b32 v36, 0
    v_mov_b32 v37, 0
    v_mov_b32 v38, 0
    v_mov_b32 v39, 0
    v_mov_b32 v40, 0
    v_mov_b32 v41, 0
    v_mov_b32 v42, 0
    v_mov_b32 v43, 0
    v_mov_b32 v44, 0
    v_mov_b32 v45, 0
    v_mov_b32 v46, 0
    v_mov_b32 v47, 0
    v_mov_b32 v13, 0xff800000
    v_mov_b32 v186, 0
    v_mov_b32 v184, 0x10000
    v_mov_b32 v187, 16
    v_mov_b32 v188, 1
    s_mov_b32 s46, 0
    v_mov_b32 v16, -1
    ds_write_b32 v87, v16 offset:16
    ds_write_b128 v186, v[36:39]
    s_waitcnt lgkmcnt(0)
    s_barrier
    s_waitcnt vmcnt(8)
    ds_read_b128 v[52:55], v18 offset:0
    ds_read_b128 v[56:59], v18 offset:64
    ds_read_b128 v[60:63], v18 offset:128
    ds_read_b128 v[64:67], v18 offset:192
    v_add_u32 v18, s49, v19
L_loop1:
    s_add_u32 s48, s48, 65536
    s_add_u32 m0, s47, 8192
    s_waitcnt vmcnt(4)
    buffer_load_dwordx4 v1, s[16:19], s48 offen offset:0 nt lds
    ds_read_b128 v[68:71], v5 offset:0
    ds_read_b128 v[72:75], v6 offset:0
    ds_read_b128 v[76:79], v7 offset:0
    ds_read_b128 v[80:83], v8 offset:0
    s_waitcnt vmcnt(4)
    buffer_load_dwordx4 v2, s[16:19], s48 offen offset:1024 nt lds
    s_waitcnt lgkmcnt(3)
    v_mfma_f32_16x16x32_bf16 v[20:23], v[68:71], v[52:55], 0
    s_waitcnt lgkmcnt(2)
    v_mfma_f32_16x16x32_bf16 v[20:23], v[72:75], v[56:59], v[20:23]
    s_waitcnt lgkmcnt(1)
    v_mfma_f32_16x16x32_bf16 v[20:23], v[76:79], v[60:63], v[20:23]
    s_waitcnt lgkmcnt(0)
    v_mfma_f32_16x16x32_bf16 v[20:23], v[80:83], v[64:67], v[20:23]
    s_waitcnt vmcnt(4)
    buffer_load_dwordx4 v3, s[16:19], s48 offen offset:2048 nt lds
    s_nop 5
    ds_write_b128 v84, v[20:23] offset:0
    v_max3_f32 v13, v13, v20, v21
    v_max3_f32 v13, v13, v22, v23
L_e2:
    s_cbranch_execz L_eback
    s_waitcnt vmcnt(4)
    buffer_load_dwordx4 v4, s[16:19], s48 offen offset:3072 nt lds
    s_add_u32 s48, s48, 65536
    s_add_u32 m0, s47, 12288
    s_waitcnt vmcnt(4)
    buffer_load_dwordx4 v1, s[16:19], s48 offen offset:0 nt lds
    ds_read_b128 v[68:71], v5 offset:4096
    ds_read_b128 v[72:75], v6 offset:4096
    ds_read_b128 v[76:79], v7 offset:4096
    ds_read_b128 v[80:83], v8 offset:4096
    s_waitcnt vmcnt(4)
    buffer_load_dwordx4 v2, s[16:19], s48 offen offset:1024 nt lds
    s_waitcnt lgkmcnt(3)
    v_mfma_f32_16x16x32_bf16 v[20:23], v[68:71], v[52:55], 0
    s_waitcnt lgkmcnt(2)
    v_mfma_f32_16x16x32_bf16 v[20:23], v[72:75], v[56:59], v[20:23]
    s_waitcnt lgkmcnt(1)
    v_mfma_f32_16x16x32_bf16 v[20:23], v[76:79], v[60:63], v[20:23]
    s_waitcnt lgkmcnt(0)
    v_mfma_f32_16x16x32_bf16 v[20:23], v[80:83], v[64:67], v[20:23]
    s_waitcnt vmcnt(4)
    buffer_load_dwordx4 v3, s[16:19], s48 offen offset:2048 nt lds
    s_nop 5
    ds_write_b128 v84, v[20:23] offset:256
    v_max3_f32 v13, v13, v20, v21
    v_max3_f32 v13, v13, v22, v23
    s_waitcnt vmcnt(4)
    buffer_load_dwordx4 v4, s[16:19], s48 offen offset:3072 nt lds
    s_add_u32 s48, s48, 65536
    s_add_u32 m0, s47, 0
    s_waitcnt vmcnt(4)
    buffer_load_dwordx4 v1, s[16:19], s48 offen offset:0 nt lds
    ds_read_b128 v[68:71], v5 offset:8192
    ds_read_b128 v[72:75], v6 offset:8192
    ds_read_b128 v[76:79], v7 offset:8192
    ds_read_b128 v[80:83], v8 offset:8192
    s_waitcnt vmcnt(4)
    buffer_load_dwordx4 v2, s[16:19], s48 offen offset:1024 nt lds
    s_waitcnt lgkmcnt(3)
    v_mfma_f32_16x16x32_bf16 v[20:23], v[68:71], v[52:55], 0
    s_waitcnt lgkmcnt(2)
    v_mfma_f32_16x16x32_bf16 v[20:23], v[72:75], v[56:59], v[20:23]
    s_waitcnt lgkmcnt(1)
    v_mfma_f32_16x16x32_bf16 v[20:23], v[76:79], v[60:63], v[20:23]
    s_waitcnt lgkmcnt(0)
    v_mfma_f32_16x16x32_bf16 v[20:23], v[80:83], v[64:67], v[20:23]
    s_waitcnt vmcnt(4)
    buffer_load_dwordx4 v3, s[16:19], s48 offen offset:2048 nt lds
    s_nop 5
    ds_write_b128 v84, v[20:23] offset:512
    v_max3_f32 v13, v13, v20, v21
    v_max3_f32 v13, v13, v22, v23
    s_waitcnt vmcnt(4)
    buffer_load_dwordx4 v4, s[16:19], s48 offen offset:3072 nt lds
    s_add_u32 s48, s48, 65536
    s_add_u32 m0, s47, 4096
    s_waitcnt vmcnt(4)
    buffer_load_dwordx4 v1, s[16:19], s48 offen offset:0 nt lds
    ds_read_b128 v[68:71], v5 offset:12288
    ds_read_b128 v[72:75], v6 offset:12288
    ds_read_b128 v[76:79], v7 offset:12288
    ds_read_b128 v[80:83], v8 offset:12288
L_e3:
    s_cbranch_execz L_eback
    s_waitcnt vmcnt(4)
    buffer_load_dwordx4 v2, s[16:19], s48 offen offset:1024 nt lds
    s_waitcnt lgkmcnt(3)
    v_mfma_f32_16x16x32_bf16 v[20:23], v[68:71], v[52:55], 0
    s_waitcnt lgkmcnt(2)
    v_mfma_f32_16x16x32_bf16 v[20:23], v[72:75], v[56:59], v[20:23]
    s_waitcnt lgkmcnt(1)
    v_mfma_f32_16x16x32_bf16 v[20:23], v[76:79], v[60:63], v[20:23]
    s_waitcnt lgkmcnt(0)
    v_mfma_f32_16x16x32_bf16 v[20:23], v[80:83], v[64:67], v[20:23]
    s_waitcnt vmcnt(4)
    buffer_load_dwordx4 v3, s[16:19], s48 offen offset:2048 nt lds
    s_nop 5
    ds_write_b128 v84, v[20:23] offset:768
    v_max3_f32 v13, v13, v20, v21
    v_max3_f32 v13, v13, v22, v23
    s_waitcnt vmcnt(4)
    buffer_load_dwordx4 v4, s[16:19], s48 offen offset:3072 nt lds
    v_add_u32 v84, 1024, v84
    s_add_u32 s46, s46, 1
    s_cmp_lt_u32 s46, 7
    s_cbranch_scc1 L_loop1
L_w0:
    s_cbranch_execz L_w1
    s_lshl_b32 s48, s41, 14
    s_waitcnt vmcnt(4)
    buffer_load_dwordx4 v[88:91], v9, s[20:23], s48 offen offset:0 nt
    ds_read_b128 v[68:71], v5 offset:0
    ds_read_b128 v[72:75], v6 offset:0
    ds_read_b128 v[76:79], v7 offset:0
    ds_read_b128 v[80:83], v8 offset:0
    s_waitcnt vmcnt(4)
    buffer_load_dwordx4 v[92:95], v9, s[20:23], s48 offen offset:1024 nt
    s_waitcnt lgkmcnt(3)
    v_mfma_f32_16x16x32_bf16 v[20:23], v[68:71], v[52:55], 0
    s_waitcnt lgkmcnt(2)
    v_mfma_f32_16x16x32_bf16 v[20:23], v[72:75], v[56:59], v[20:23]
    s_waitcnt lgkmcnt(1)
    v_mfma_f32_16x16x32_bf16 v[20:23], v[76:79], v[60:63], v[20:23]
    s_waitcnt lgkmcnt(0)
    v_mfma_f32_16x16x32_bf16 v[20:23], v[80:83], v[64:67], v[20:23]
    s_waitcnt vmcnt(4)
    buffer_load_dwordx4 v[96:99], v9, s[20:23], s48 offen offset:2048 nt
    s_nop 5
    ds_write_b128 v84, v[20:23] offset:0
    v_max3_f32 v13, v13, v20, v21
    v_max3_f32 v13, v13, v22, v23
    s_waitcnt vmcnt(4)
    buffer_load_dwordx4 v[100:103], v9, s[20:23], s48 offen offset:3072 nt
    s_add_u32 s48, s48, 65536
    s_waitcnt vmcnt(4)
    buffer_load_dwordx4 v[104:107], v9, s[20:23], s48 offen offset:0 nt
    ds_read_b128 v[68:71], v5 offset:4096
    ds_read_b128 v[72:75], v6 offset:4096
    ds_read_b128 v[76:79], v7 offset:4096
    ds_read_b128 v[80:83], v8 offset:4096
    s_waitcnt vmcnt(4)
    buffer_load_dwordx4 v[108:111], v9, s[20:23], s48 offen offset:1024 nt
    s_waitcnt lgkmcnt(3)
    v_mfma_f32_16x16x32_bf16 v[20:23], v[68:71], v[52:55], 0
    s_waitcnt lgkmcnt(2)
    v_mfma_f32_16x16x32_bf16 v[20:23], v[72:75], v[56:59], v[20:23]
    s_waitcnt lgkmcnt(1)
    v_mfma_f32_16x16x32_bf16 v[20:23], v[76:79], v[60:63], v[20:23]
L_w1:
    s_cbranch_execz L_w2
    s_waitcnt lgkmcnt(0)
    v_mfma_f32_16x16x32_bf16 v[20:23], v[80:83], v[64:67], v[20:23]
    ds_read_b128 v[24:27], v86 offset:0
    s_waitcnt vmcnt(4)
    buffer_load_dwordx4 v[112:115], v9, s[20:23], s48 offen offset:2048 nt
    s_nop 5
    ds_write_b128 v84, v[20:23] offset:256
    v_max3_f32 v13, v13, v20, v21
    v_max3_f32 v13, v13, v22, v23
    v_mov_b32 v17, v13
    s_nop 1
    v_permlane16_swap_b32 v13, v17
    s_nop 0
    v_max_f32 v13, v13, v17
    v_mov_b32 v17, v13
    s_nop 1
    v_permlane32_swap_b32 v13, v17
    s_nop 0
    v_max_f32 v13, v13, v17
    v_mul_f32 v14, s43, v13
    s_waitcnt lgkmcnt(0)
    v_fma_f32 v24, v24, s43, -v14
    v_fma_f32 v25, v25, s43, -v14
    v_fma_f32 v26, v26, s43, -v14
    v_fma_f32 v27, v27, s43, -v14
    v_exp_f32 v24, v24
    v_exp_f32 v25, v25
    v_exp_f32 v26, v26
    v_exp_f32 v27, v27
    s_waitcnt vmcnt(4)
    buffer_load_dwordx4 v[116:119], v9, s[20:23], s48 offen offset:3072 nt
    v_cvt_pk_bf16_f32 v24, v24, v24
    v_cvt_pk_bf16_f32 v25, v25, v25
    v_cvt_pk_bf16_f32 v26, v26, v26
    v_cvt_pk_bf16_f32 v27, v27, v27
    v_and_b32 v28, v24, v11
    v_and_b32 v29, v24, v12
    v_and_b32 v30, v25, v11
    v_and_b32 v31, v25, v12
    v_and_b32 v32, v26, v11
    v_and_b32 v33, v26, v12
    v_and_b32 v34, v27, v11
    v_and_b32 v35, v27, v12
    v_mfma_f32_16x16x16_bf16 v[36:39], v[28:29], v[88:89], v[36:39]
    v_mfma_f32_16x16x16_bf16 v[40:43], v[28:29], v[90:91], v[40:43]
    v_mfma_f32_16x16x16_bf16 v[36:39], v[30:31], v[92:93], v[36:39]
    v_mfma_f32_16x16x16_bf16 v[40:43], v[30:31], v[94:95], v[40:43]
    v_mfma_f32_16x16x16_bf16 v[36:39], v[32:33], v[96:97], v[36:39]
    v_mfma_f32_16x16x16_bf16 v[40:43], v[32:33], v[98:99], v[40:43]
    v_mfma_f32_16x16x32_bf16 v[44:47], v[28:31], v[48:51], v[44:47]
    v_mfma_f32_16x16x32_bf16 v[44:47], v[32:35], v[48:51], v[44:47]
    s_add_u32 s48, s48, 65536
L_w2:
    s_cbranch_execz L_w3
    s_waitcnt vmcnt(4)
    buffer_load_dwordx4 v[120:123], v9, s[20:23], s48 offen offset:0 nt
    v_mfma_f32_16x16x16_bf16 v[36:39], v[34:35], v[100:101], v[36:39]
    v_mfma_f32_16x16x16_bf16 v[40:43], v[34:35], v[102:103], v[40:43]
    s_mov_b64 exec, 1
    ds_max_u32 v186, v188 offset:8
    s_mov_b64 exec, -1
    v_add_u32 v188, 1, v188
    s_mov_b32 s46, 0
L_loop2:
    s_waitcnt vmcnt(4)
    buffer_load_dwordx4 v[124:127], v9, s[20:23], s48 offen offset:1024 nt
    ds_read_b128 v[24:27], v86 offset:256
    s_waitcnt vmcnt(4)
    buffer_load_dwordx4 v[128:131], v9, s[20:23], s48 offen offset:2048 nt
    s_waitcnt lgkmcnt(0)
    v_fma_f32 v24, v24, s43, -v14
    v_fma_f32 v25, v25, s43, -v14
    v_fma_f32 v26, v26, s43, -v14
    v_fma_f32 v27, v27, s43, -v14
    v_exp_f32 v24, v24
    v_exp_f32 v25, v25
    v_exp_f32 v26, v26
    v_exp_f32 v27, v27
    s_waitcnt vmcnt(4)
    buffer_load_dwordx4 v[132:135], v9, s[20:23], s48 offen offset:3072 nt
    v_cvt_pk_bf16_f32 v24, v24, v24
    v_cvt_pk_bf16_f32 v25, v25, v25
    v_cvt_pk_bf16_f32 v26, v26, v26
    v_cvt_pk_bf16_f32 v27, v27, v27
    v_and_b32 v28, v24, v11
    v_and_b32 v29, v24, v12
    v_and_b32 v30, v25, v11
    v_and_b32 v31, v25, v12
    v_and_b32 v32, v26, v11
    v_and_b32 v33, v26, v12
    v_and_b32 v34, v27, v11
    v_and_b32 v35, v27, v12
    v_mfma_f32_16x16x16_bf16 v[36:39], v[28:29], v[104:105], v[36:39]
    v_mfma_f32_16x16x16_bf16 v[40:43], v[28:29], v[106:107], v[40:43]
    v_mfma_f32_16x16x16_bf16 v[36:39], v[30:31], v[108:109], v[36:39]
    v_mfma_f32_16x16x16_bf16 v[40:43], v[30:31], v[110:111], v[40:43]
    v_mfma_f32_16x16x16_bf16 v[36:39], v[32:33], v[112:113], v[36:39]
    v_mfma_f32_16x16x16_bf16 v[40:43], v[32:33], v[114:115], v[40:43]
    v_mfma_f32_16x16x32_bf16 v[44:47], v[28:31], v[48:51], v[44:47]
    v_mfma_f32_16x16x32_bf16 v[44:47], v[32:35], v[48:51], v[44:47]
    s_add_u32 s48, s48, 65536
L_w3:
    s_cbranch_execz L_w4
    s_waitcnt vmcnt(4)
    buffer_load_dwordx4 v[136:139], v9, s[20:23], s48 offen offset:0 nt
    v_mfma_f32_16x16x16_bf16 v[36:39], v[34:35], v[116:117], v[36:39]
    v_mfma_f32_16x16x16_bf16 v[40:43], v[34:35], v[118:119], v[40:43]
    s_waitcnt vmcnt(4)
    buffer_load_dwordx4 v[140:143], v9, s[20:23], s48 offen offset:1024 nt
    ds_read_b128 v[24:27], v86 offset:512
    s_waitcnt vmcnt(4)
    buffer_load_dwordx4 v[144:147], v9, s[20:23], s48 offen offset:2048 nt
    s_waitcnt lgkmcnt(0)
    v_fma_f32 v24, v24, s43, -v14
    v_fma_f32 v25, v25, s43, -v14
    v_fma_f32 v26, v26, s43, -v14
    v_fma_f32 v27, v27, s43, -v14
    v_exp_f32 v24, v24
    v_exp_f32 v25, v25
    v_exp_f32 v26, v26
    v_exp_f32 v27, v27
    s_waitcnt vmcnt(4)
    buffer_load_dwordx4 v[148:151], v9, s[20:23], s48 offen offset:3072 nt
    v_cvt_pk_bf16_f32 v24, v24, v24
    v_cvt_pk_bf16_f32 v25, v25, v25
    v_cvt_pk_bf16_f32 v26, v26, v26
    v_cvt_pk_bf16_f32 v27, v27, v27
    v_and_b32 v28, v24, v11
    v_and_b32 v29, v24, v12
    v_and_b32 v30, v25, v11
    v_and_b32 v31, v25, v12
    v_and_b32 v32, v26, v11
    v_and_b32 v33, v26, v12
    v_and_b32 v34, v27, v11
    v_and_b32 v35, v27, v12
    v_mfma_f32_16x16x16_bf16 v[36:39], v[28:29], v[120:121], v[36:39]
    v_mfma_f32_16x16x16_bf16 v[40:43], v[28:29], v[122:123], v[40:43]
    v_mfma_f32_16x16x16_bf16 v[36:39], v[30:31], v[124:125], v[36:39]
    v_mfma_f32_16x16x16_bf16 v[40:43], v[30:31], v[126:127], v[40:43]
    v_mfma_f32_16x16x16_bf16 v[36:39], v[32:33], v[128:129], v[36:39]
    v_mfma_f32_16x16x16_bf16 v[40:43], v[32:33], v[130:131], v[40:43]
    v_mfma_f32_16x16x32_bf16 v[44:47], v[28:31], v[48:51], v[44:47]
    v_mfma_f32_16x16x32_bf16 v[44:47], v[32:35], v[48:51], v[44:47]
    s_add_u32 s48, s48, 65536
L_w4:
    s_cbranch_execz L_w5
    s_waitcnt vmcnt(4)
    buffer_load_dwordx4 v[88:91], v9, s[20:23], s48 offen offset:0 nt
    v_mfma_f32_16x16x16_bf16 v[36:39], v[34:35], v[132:133], v[36:39]
    v_mfma_f32_16x16x16_bf16 v[40:43], v[34:35], v[134:135], v[40:43]
    s_waitcnt vmcnt(4)
    buffer_load_dwordx4 v[92:95], v9, s[20:23], s48 offen offset:1024 nt
    ds_read_b128 v[24:27], v86 offset:768
    s_waitcnt vmcnt(4)
    buffer_load_dwordx4 v[96:99], v9, s[20:23], s48 offen offset:2048 nt
    s_waitcnt lgkmcnt(0)
    v_fma_f32 v24, v24, s43, -v14
    v_fma_f32 v25, v25, s43, -v14
    v_fma_f32 v26, v26, s43, -v14
    v_fma_f32 v27, v27, s43, -v14
    v_exp_f32 v24, v24
    v_exp_f32 v25, v25
    v_exp_f32 v26, v26
    v_exp_f32 v27, v27
    s_waitcnt vmcnt(4)
    buffer_load_dwordx4 v[100:103], v9, s[20:23], s48 offen offset:3072 nt
    v_cvt_pk_bf16_f32 v24, v24, v24
    v_cvt_pk_bf16_f32 v25, v25, v25
    v_cvt_pk_bf16_f32 v26, v26, v26
    v_cvt_pk_bf16_f32 v27, v27, v27
    v_and_b32 v28, v24, v11
    v_and_b32 v29, v24, v12
    v_and_b32 v30, v25, v11
    v_and_b32 v31, v25, v12
    v_and_b32 v32, v26, v11
    v_and_b32 v33, v26, v12
    v_and_b32 v34, v27, v11
    v_and_b32 v35, v27, v12
    v_mfma_f32_16x16x16_bf16 v[36:39], v[28:29], v[136:137], v[36:39]
    v_mfma_f32_16x16x16_bf16 v[40:43], v[28:29], v[138:139], v[40:43]
    v_mfma_f32_16x16x16_bf16 v[36:39], v[30:31], v[140:141], v[36:39]
    v_mfma_f32_16x16x16_bf16 v[40:43], v[30:31], v[142:143], v[40:43]
    v_mfma_f32_16x16x16_bf16 v[36:39], v[32:33], v[144:145], v[36:39]
    v_mfma_f32_16x16x16_bf16 v[40:43], v[32:33], v[146:147], v[40:43]
    v_mfma_f32_16x16x32_bf16 v[44:47], v[28:31], v[48:51], v[44:47]
    v_mfma_f32_16x16x32_bf16 v[44:47], v[32:35], v[48:51], v[44:47]
    s_add_u32 s48, s48, 65536
L_w5:
    s_cbranch_execz L_w6
    s_waitcnt vmcnt(4)
    buffer_load_dwordx4 v[104:107], v9, s[20:23], s48 offen offset:0 nt
    v_mfma_f32_16x16x16_bf16 v[36:39], v[34:35], v[148:149], v[36:39]
    v_mfma_f32_16x16x16_bf16 v[40:43], v[34:35], v[150:151], v[40:43]
    s_waitcnt vmcnt(4)
    buffer_load_dwordx4 v[108:111], v9, s[20:23], s48 offen offset:1024 nt
    ds_read_b128 v[24:27], v86 offset:1024
    s_waitcnt vmcnt(4)
    buffer_load_dwordx4 v[112:115], v9, s[20:23], s48 offen offset:2048 nt
    s_waitcnt lgkmcnt(0)
    v_fma_f32 v24, v24, s43, -v14
    v_fma_f32 v25, v25, s43, -v14
    v_fma_f32 v26, v26, s43, -v14
    v_fma_f32 v27, v27, s43, -v14
    v_exp_f32 v24, v24
    v_exp_f32 v25, v25
    v_exp_f32 v26, v26
    v_exp_f32 v27, v27
    s_waitcnt vmcnt(4)
    buffer_load_dwordx4 v[116:119], v9, s[20:23], s48 offen offset:3072 nt
    v_cvt_pk_bf16_f32 v24, v24, v24
    v_cvt_pk_bf16_f32 v25, v25, v25
    v_cvt_pk_bf16_f32 v26, v26, v26
    v_cvt_pk_bf16_f32 v27, v27, v27
    v_and_b32 v28, v24, v11
    v_and_b32 v29, v24, v12
    v_and_b32 v30, v25, v11
    v_and_b32 v31, v25, v12
    v_and_b32 v32, v26, v11
    v_and_b32 v33, v26, v12
    v_and_b32 v34, v27, v11
    v_and_b32 v35, v27, v12
    v_mfma_f32_16x16x16_bf16 v[36:39], v[28:29], v[88:89], v[36:39]
    v_mfma_f32_16x16x16_bf16 v[40:43], v[28:29], v[90:91], v[40:43]
    v_mfma_f32_16x16x16_bf16 v[36:39], v[30:31], v[92:93], v[36:39]
    v_mfma_f32_16x16x16_bf16 v[40:43], v[30:31], v[94:95], v[40:43]
    v_mfma_f32_16x16x16_bf16 v[36:39], v[32:33], v[96:97], v[36:39]
    v_mfma_f32_16x16x16_bf16 v[40:43], v[32:33], v[98:99], v[40:43]
    v_mfma_f32_16x16x32_bf16 v[44:47], v[28:31], v[48:51], v[44:47]
    v_mfma_f32_16x16x32_bf16 v[44:47], v[32:35], v[48:51], v[44:47]
    s_add_u32 s48, s48, 65536
L_w6:
    s_cbranch_execz L_w7
    s_waitcnt vmcnt(4)
    buffer_load_dwordx4 v[120:123], v9, s[20:23], s48 offen offset:0 nt
    v_mfma_f32_16x16x16_bf16 v[36:39], v[34:35], v[100:101], v[36:39]
    v_mfma_f32_16x16x16_bf16 v[40:43], v[34:35], v[102:103], v[40:43]
    v_add_u32 v86, 1024, v86
    s_add_u32 s46, s46, 1
    s_cmp_lt_u32 s46, 5
    s_cbranch_scc1 L_loop2
    s_mov_b64 exec, 1
    ds_max_u32 v186, v188 offset:8
    s_mov_b64 exec, -1
    v_add_u32 v188, 1, v188
    s_waitcnt vmcnt(4)
    buffer_load_dwordx4 v[124:127], v9, s[20:23], s48 offen offset:1024 nt
    ds_read_b128 v[24:27], v86 offset:256
    s_waitcnt vmcnt(4)
    buffer_load_dwordx4 v[128:131], v9, s[20:23], s48 offen offset:2048 nt
    s_waitcnt lgkmcnt(0)
    v_fma_f32 v24, v24, s43, -v14
    v_fma_f32 v25, v25, s43, -v14
    v_fma_f32 v26, v26, s43, -v14
    v_fma_f32 v27, v27, s43, -v14
    v_exp_f32 v24, v24
    v_exp_f32 v25, v25
    v_exp_f32 v26, v26
    v_exp_f32 v27, v27
    s_waitcnt vmcnt(4)
    buffer_load_dwordx4 v[132:135], v9, s[20:23], s48 offen offset:3072 nt
    v_cvt_pk_bf16_f32 v24, v24, v24
    v_cvt_pk_bf16_f32 v25, v25, v25
    v_cvt_pk_bf16_f32 v26, v26, v26
    v_cvt_pk_bf16_f32 v27, v27, v27
    v_and_b32 v28, v24, v11
    v_and_b32 v29, v24, v12
    v_and_b32 v30, v25, v11
    v_and_b32 v31, v25, v12
    v_and_b32 v32, v26, v11
    v_and_b32 v33, v26, v12
    v_and_b32 v34, v27, v11
    v_and_b32 v35, v27, v12
    v_mfma_f32_16x16x16_bf16 v[36:39], v[28:29], v[104:105], v[36:39]
    v_mfma_f32_16x16x16_bf16 v[40:43], v[28:29], v[106:107], v[40:43]
    v_mfma_f32_16x16x16_bf16 v[36:39], v[30:31], v[108:109], v[36:39]
    v_mfma_f32_16x16x16_bf16 v[40:43], v[30:31], v[110:111], v[40:43]
    v_mfma_f32_16x16x16_bf16 v[36:39], v[32:33], v[112:113], v[36:39]
    v_mfma_f32_16x16x16_bf16 v[40:43], v[32:33], v[114:115], v[40:43]
    v_mfma_f32_16x16x32_bf16 v[44:47], v[28:31], v[48:51], v[44:47]
    v_mfma_f32_16x16x32_bf16 v[44:47], v[32:35], v[48:51], v[44:47]
    s_add_u32 s48, s48, 65536
L_w7:
    s_cbranch_execz L_w8
    s_waitcnt vmcnt(4)
    buffer_load_dwordx4 v[136:139], v9, s[20:23], s48 offen offset:0 nt
    v_mfma_f32_16x16x16_bf16 v[36:39], v[34:35], v[116:117], v[36:39]
    v_mfma_f32_16x16x16_bf16 v[40:43], v[34:35], v[118:119], v[40:43]
    s_waitcnt vmcnt(4)
    buffer_load_dwordx4 v[140:143], v9, s[20:23], s48 offen offset:1024 nt
    ds_read_b128 v[24:27], v86 offset:512
    s_waitcnt vmcnt(4)
    buffer_load_dwordx4 v[144:147], v9, s[20:23], s48 offen offset:2048 nt
    s_waitcnt lgkmcnt(0)
    v_fma_f32 v24, v24, s43, -v14
    v_fma_f32 v25, v25, s43, -v14
    v_fma_f32 v26, v26, s43, -v14
    v_fma_f32 v27, v27, s43, -v14
    v_exp_f32 v24, v24
    v_exp_f32 v25, v25
    v_exp_f32 v26, v26
    v_exp_f32 v27, v27
    s_waitcnt vmcnt(4)
    buffer_load_dwordx4 v[148:151], v9, s[20:23], s48 offen offset:3072 nt
    v_cvt_pk_bf16_f32 v24, v24, v24
    v_cvt_pk_bf16_f32 v25, v25, v25
    v_cvt_pk_bf16_f32 v26, v26, v26
    v_cvt_pk_bf16_f32 v27, v27, v27
    v_and_b32 v28, v24, v11
    v_and_b32 v29, v24, v12
    v_and_b32 v30, v25, v11
    v_and_b32 v31, v25, v12
    v_and_b32 v32, v26, v11
    v_and_b32 v33, v26, v12
    v_and_b32 v34, v27, v11
    v_and_b32 v35, v27, v12
    v_mfma_f32_16x16x16_bf16 v[36:39], v[28:29], v[120:121], v[36:39]
    v_mfma_f32_16x16x16_bf16 v[40:43], v[28:29], v[122:123], v[40:43]
    v_mfma_f32_16x16x16_bf16 v[36:39], v[30:31], v[124:125], v[36:39]
    v_mfma_f32_16x16x16_bf16 v[40:43], v[30:31], v[126:127], v[40:43]
    v_mfma_f32_16x16x16_bf16 v[36:39], v[32:33], v[128:129], v[36:39]
    v_mfma_f32_16x16x16_bf16 v[40:43], v[32:33], v[130:131], v[40:43]
    v_mfma_f32_16x16x32_bf16 v[44:47], v[28:31], v[48:51], v[44:47]
    v_mfma_f32_16x16x32_bf16 v[44:47], v[32:35], v[48:51], v[44:47]
    s_add_u32 s48, s48, 65536
L_w8:
    s_cbranch_execz L_w9
    s_waitcnt vmcnt(4)
    buffer_load_dwordx4 v[88:91], v9, s[20:23], s48 offen offset:0 nt
    v_mfma_f32_16x16x16_bf16 v[36:39], v[34:35], v[132:133], v[36:39]
    v_mfma_f32_16x16x16_bf16 v[40:43], v[34:35], v[134:135], v[40:43]
    s_waitcnt vmcnt(4)
    buffer_load_dwordx4 v[92:95], v9, s[20:23], s48 offen offset:1024 nt
    ds_read_b128 v[24:27], v86 offset:768
    s_waitcnt vmcnt(4)
    buffer_load_dwordx4 v[96:99], v9, s[20:23], s48 offen offset:2048 nt
    s_waitcnt lgkmcnt(0)
    v_fma_f32 v24, v24, s43, -v14
    v_fma_f32 v25, v25, s43, -v14
    v_fma_f32 v26, v26, s43, -v14
    v_fma_f32 v27, v27, s43, -v14
    v_exp_f32 v24, v24
    v_exp_f32 v25, v25
    v_exp_f32 v26, v26
    v_exp_f32 v27, v27
    s_waitcnt vmcnt(4)
    buffer_load_dwordx4 v[100:103], v9, s[20:23], s48 offen offset:3072 nt
    v_cvt_pk_bf16_f32 v24, v24, v24
    v_cvt_pk_bf16_f32 v25, v25, v25
    v_cvt_pk_bf16_f32 v26, v26, v26
    v_cvt_pk_bf16_f32 v27, v27, v27
    v_and_b32 v28, v24, v11
    v_and_b32 v29, v24, v12
    v_and_b32 v30, v25, v11
    v_and_b32 v31, v25, v12
    v_and_b32 v32, v26, v11
    v_and_b32 v33, v26, v12
    v_and_b32 v34, v27, v11
    v_and_b32 v35, v27, v12
    v_mfma_f32_16x16x16_bf16 v[36:39], v[28:29], v[136:137], v[36:39]
    v_mfma_f32_16x16x16_bf16 v[40:43], v[28:29], v[138:139], v[40:43]
    v_mfma_f32_16x16x16_bf16 v[36:39], v[30:31], v[140:141], v[36:39]
    v_mfma_f32_16x16x16_bf16 v[40:43], v[30:31], v[142:143], v[40:43]
    v_mfma_f32_16x16x16_bf16 v[36:39], v[32:33], v[144:145], v[36:39]
    v_mfma_f32_16x16x16_bf16 v[40:43], v[32:33], v[146:147], v[40:43]
    v_mfma_f32_16x16x32_bf16 v[44:47], v[28:31], v[48:51], v[44:47]
    v_mfma_f32_16x16x32_bf16 v[44:47], v[32:35], v[48:51], v[44:47]
    s_add_u32 s48, s48, 65536
L_w9:
    s_cbranch_execz L_w10
    s_waitcnt vmcnt(4)
    buffer_load_dwordx4 v[104:107], v9, s[20:23], s48 offen offset:0 nt
    v_mfma_f32_16x16x16_bf16 v[36:39], v[34:35], v[148:149], v[36:39]
    v_mfma_f32_16x16x16_bf16 v[40:43], v[34:35], v[150:151], v[40:43]
    s_waitcnt vmcnt(4)
    buffer_load_dwordx4 v[108:111], v9, s[20:23], s48 offen offset:1024 nt
    ds_read_b128 v[24:27], v86 offset:1024
    s_waitcnt vmcnt(4)
    buffer_load_dwordx4 v[112:115], v9, s[20:23], s48 offen offset:2048 nt
    s_waitcnt lgkmcnt(0)
    v_fma_f32 v24, v24, s43, -v14
    v_fma_f32 v25, v25, s43, -v14
    v_fma_f32 v26, v26, s43, -v14
    v_fma_f32 v27, v27, s43, -v14
    v_exp_f32 v24, v24
    v_exp_f32 v25, v25
    v_exp_f32 v26, v26
    v_exp_f32 v27, v27
    s_waitcnt vmcnt(4)
    buffer_load_dwordx4 v[116:119], v9, s[20:23], s48 offen offset:3072 nt
    v_cvt_pk_bf16_f32 v24, v24, v24
    v_cvt_pk_bf16_f32 v25, v25, v25
    v_cvt_pk_bf16_f32 v26, v26, v26
    v_cvt_pk_bf16_f32 v27, v27, v27
    v_and_b32 v28, v24, v11
    v_and_b32 v29, v24, v12
    v_and_b32 v30, v25, v11
    v_and_b32 v31, v25, v12
    v_and_b32 v32, v26, v11
    v_and_b32 v33, v26, v12
    v_and_b32 v34, v27, v11
    v_and_b32 v35, v27, v12
    v_mfma_f32_16x16x16_bf16 v[36:39], v[28:29], v[88:89], v[36:39]
    v_mfma_f32_16x16x16_bf16 v[40:43], v[28:29], v[90:91], v[40:43]
    v_mfma_f32_16x16x16_bf16 v[36:39], v[30:31], v[92:93], v[36:39]
    v_mfma_f32_16x16x16_bf16 v[40:43], v[30:31], v[94:95], v[40:43]
    v_mfma_f32_16x16x16_bf16 v[36:39], v[32:33], v[96:97], v[36:39]
    v_mfma_f32_16x16x16_bf16 v[40:43], v[32:33], v[98:99], v[40:43]
    v_mfma_f32_16x16x32_bf16 v[44:47], v[28:31], v[48:51], v[44:47]
    v_mfma_f32_16x16x32_bf16 v[44:47], v[32:35], v[48:51], v[44:47]
    s_add_u32 s48, s48, 65536
L_w10:
    s_cbranch_execz L_w11
    s_waitcnt vmcnt(4)
    buffer_load_dwordx4 v[120:123], v9, s[20:23], s48 offen offset:0 nt
    v_mfma_f32_16x16x16_bf16 v[36:39], v[34:35], v[100:101], v[36:39]
    v_mfma_f32_16x16x16_bf16 v[40:43], v[34:35], v[102:103], v[40:43]
    s_waitcnt vmcnt(4)
    buffer_load_dwordx4 v[124:127], v9, s[20:23], s48 offen offset:1024 nt
    ds_read_b128 v[24:27], v86 offset:1280
    s_waitcnt vmcnt(4)
    buffer_load_dwordx4 v[128:131], v9, s[20:23], s48 offen offset:2048 nt
    s_waitcnt lgkmcnt(0)
    v_fma_f32 v24, v24, s43, -v14
    v_fma_f32 v25, v25, s43, -v14
    v_fma_f32 v26, v26, s43, -v14
    v_fma_f32 v27, v27, s43, -v14
    v_exp_f32 v24, v24
    v_exp_f32 v25, v25
    v_exp_f32 v26, v26
    v_exp_f32 v27, v27
    s_mov_b64 exec, 1
    ds_max_u32 v186, v188 offset:8
    s_mov_b64 exec, -1
    v_add_u32 v188, 1, v188
    s_waitcnt vmcnt(4)
    buffer_load_dwordx4 v[132:135], v9, s[20:23], s48 offen offset:3072 nt
    v_cvt_pk_bf16_f32 v24, v24, v24
    v_cvt_pk_bf16_f32 v25, v25, v25
    v_cvt_pk_bf16_f32 v26, v26, v26
    v_cvt_pk_bf16_f32 v27, v27, v27
    v_and_b32 v28, v24, v11
    v_and_b32 v29, v24, v12
    v_and_b32 v30, v25, v11
    v_and_b32 v31, v25, v12
    v_and_b32 v32, v26, v11
    v_and_b32 v33, v26, v12
    v_and_b32 v34, v27, v11
    v_and_b32 v35, v27, v12
    v_mfma_f32_16x16x16_bf16 v[36:39], v[28:29], v[104:105], v[36:39]
    v_mfma_f32_16x16x16_bf16 v[40:43], v[28:29], v[106:107], v[40:43]
    v_mfma_f32_16x16x16_bf16 v[36:39], v[30:31], v[108:109], v[36:39]
    v_mfma_f32_16x16x16_bf16 v[40:43], v[30:31], v[110:111], v[40:43]
    v_mfma_f32_16x16x16_bf16 v[36:39], v[32:33], v[112:113], v[36:39]
    v_mfma_f32_16x16x16_bf16 v[40:43], v[32:33], v[114:115], v[40:43]
    v_mfma_f32_16x16x32_bf16 v[44:47], v[28:31], v[48:51], v[44:47]
    v_mfma_f32_16x16x32_bf16 v[44:47], v[32:35], v[48:51], v[44:47]
    s_add_u32 s48, s48, 65536
L_w11:
    s_cbranch_execz L_w12
    s_waitcnt vmcnt(4)
    buffer_load_dwordx4 v[136:139], v9, s[20:23], s48 offen offset:0 nt
    v_mfma_f32_16x16x16_bf16 v[36:39], v[34:35], v[116:117], v[36:39]
    v_mfma_f32_16x16x16_bf16 v[40:43], v[34:35], v[118:119], v[40:43]
    s_waitcnt vmcnt(4)
    buffer_load_dwordx4 v[140:143], v9, s[20:23], s48 offen offset:1024 nt
    ds_read_b128 v[24:27], v86 offset:1536
    s_waitcnt vmcnt(4)
    buffer_load_dwordx4 v[144:147], v9, s[20:23], s48 offen offset:2048 nt
    s_waitcnt lgkmcnt(0)
    v_fma_f32 v24, v24, s43, -v14
    v_fma_f32 v25, v25, s43, -v14
    v_fma_f32 v26, v26, s43, -v14
    v_fma_f32 v27, v27, s43, -v14
    v_exp_f32 v24, v24
    v_exp_f32 v25, v25
    v_exp_f32 v26, v26
    v_exp_f32 v27, v27
    s_waitcnt vmcnt(4)
    buffer_load_dwordx4 v[148:151], v9, s[20:23], s48 offen offset:3072 nt
    v_cvt_pk_bf16_f32 v24, v24, v24
    v_cvt_pk_bf16_f32 v25, v25, v25
    v_cvt_pk_bf16_f32 v26, v26, v26
    v_cvt_pk_bf16_f32 v27, v27, v27
    v_and_b32 v28, v24, v11
    v_and_b32 v29, v24, v12
    v_and_b32 v30, v25, v11
    v_and_b32 v31, v25, v12
    v_and_b32 v32, v26, v11
    v_and_b32 v33, v26, v12
    v_and_b32 v34, v27, v11
    v_and_b32 v35, v27, v12
    v_mfma_f32_16x16x16_bf16 v[36:39], v[28:29], v[120:121], v[36:39]
    v_mfma_f32_16x16x16_bf16 v[40:43], v[28:29], v[122:123], v[40:43]
    v_mfma_f32_16x16x16_bf16 v[36:39], v[30:31], v[124:125], v[36:39]
    v_mfma_f32_16x16x16_bf16 v[40:43], v[30:31], v[126:127], v[40:43]
    v_mfma_f32_16x16x16_bf16 v[36:39], v[32:33], v[128:129], v[36:39]
    v_mfma_f32_16x16x16_bf16 v[40:43], v[32:33], v[130:131], v[40:43]
    v_mfma_f32_16x16x32_bf16 v[44:47], v[28:31], v[48:51], v[44:47]
    v_mfma_f32_16x16x32_bf16 v[44:47], v[32:35], v[48:51], v[44:47]
    s_add_u32 s48, s48, 65536
L_w12:
    s_cbranch_execz L_w13
    s_waitcnt vmcnt(4)
    buffer_load_dwordx4 v[88:91], v9, s[20:23], s48 offen offset:0 nt
    v_mfma_f32_16x16x16_bf16 v[36:39], v[34:35], v[132:133], v[36:39]
    v_mfma_f32_16x16x16_bf16 v[40:43], v[34:35], v[134:135], v[40:43]
    s_waitcnt vmcnt(4)
    buffer_load_dwordx4 v[92:95], v9, s[20:23], s48 offen offset:1024 nt
    ds_read_b128 v[24:27], v86 offset:1792
    s_waitcnt vmcnt(4)
    buffer_load_dwordx4 v[96:99], v9, s[20:23], s48 offen offset:2048 nt
    s_waitcnt lgkmcnt(0)
    v_fma_f32 v24, v24, s43, -v14
    v_fma_f32 v25, v25, s43, -v14
    v_fma_f32 v26, v26, s43, -v14
    v_fma_f32 v27, v27, s43, -v14
    v_exp_f32 v24, v24
    v_exp_f32 v25, v25
    v_exp_f32 v26, v26
    v_exp_f32 v27, v27
    s_waitcnt vmcnt(4)
    buffer_load_dwordx4 v[100:103], v9, s[20:23], s48 offen offset:3072 nt
    v_cvt_pk_bf16_f32 v24, v24, v24
    v_cvt_pk_bf16_f32 v25, v25, v25
    v_cvt_pk_bf16_f32 v26, v26, v26
    v_cvt_pk_bf16_f32 v27, v27, v27
    v_and_b32 v28, v24, v11
    v_and_b32 v29, v24, v12
    v_and_b32 v30, v25, v11
    v_and_b32 v31, v25, v12
    v_and_b32 v32, v26, v11
    v_and_b32 v33, v26, v12
    v_and_b32 v34, v27, v11
    v_and_b32 v35, v27, v12
    v_mfma_f32_16x16x16_bf16 v[36:39], v[28:29], v[136:137], v[36:39]
    v_mfma_f32_16x16x16_bf16 v[40:43], v[28:29], v[138:139], v[40:43]
    v_mfma_f32_16x16x16_bf16 v[36:39], v[30:31], v[140:141], v[36:39]
    v_mfma_f32_16x16x16_bf16 v[40:43], v[30:31], v[142:143], v[40:43]
    v_mfma_f32_16x16x16_bf16 v[36:39], v[32:33], v[144:145], v[36:39]
    v_mfma_f32_16x16x16_bf16 v[40:43], v[32:33], v[146:147], v[40:43]
    v_mfma_f32_16x16x32_bf16 v[44:47], v[28:31], v[48:51], v[44:47]
    v_mfma_f32_16x16x32_bf16 v[44:47], v[32:35], v[48:51], v[44:47]
    s_add_u32 s48, s48, 65536
L_w13:
    s_cbranch_execz L_w14
    s_waitcnt vmcnt(4)
    buffer_load_dwordx4 v[104:107], v9, s[20:23], s48 offen offset:0 nt
    v_mfma_f32_16x16x16_bf16 v[36:39], v[34:35], v[148:149], v[36:39]
    v_mfma_f32_16x16x16_bf16 v[40:43], v[34:35], v[150:151], v[40:43]
    buffer_load_dwordx4 v[108:111], v9, s[20:23], s48 offen offset:1024 nt
    buffer_load_dwordx4 v[112:115], v9, s[20:23], s48 offen offset:2048 nt
    buffer_load_dwordx4 v[116:119], v9, s[20:23], s48 offen offset:3072 nt
L_qspin1:
    ds_read_b32 v189, v187
    s_waitcnt lgkmcnt(0)
    v_readfirstlane_b32 s58, v189
    s_add_u32 m0, s47, 0
    s_cmp_eq_u32 s58, -1
    s_cbranch_scc1 L_qspin1
    s_cmp_lt_u32 s58, 0x200000
    s_cselect_b32 s18, 0x200000, 0
    v_add_u32 v187, 4, v187
    s_waitcnt vmcnt(7)
    buffer_load_dwordx4 v1, s[16:19], s58 offen offset:0 nt lds
    ds_read_b128 v[24:27], v86 offset:2048
    s_waitcnt vmcnt(7)
    buffer_load_dwordx4 v2, s[16:19], s58 offen offset:1024 nt lds
    s_waitcnt lgkmcnt(0)
    v_fma_f32 v24, v24, s43, -v14
    v_fma_f32 v25, v25, s43, -v14
    v_fma_f32 v26, v26, s43, -v14
    v_fma_f32 v27, v27, s43, -v14
    v_exp_f32 v24, v24
    v_exp_f32 v25, v25
    v_exp_f32 v26, v26
    v_exp_f32 v27, v27
    s_waitcnt vmcnt(7)
    buffer_load_dwordx4 v3, s[16:19], s58 offen offset:2048 nt lds
    v_cvt_pk_bf16_f32 v24, v24, v24
    v_cvt_pk_bf16_f32 v25, v25, v25
    v_cvt_pk_bf16_f32 v26, v26, v26
    v_cvt_pk_bf16_f32 v27, v27, v27
    v_and_b32 v28, v24, v11
    v_and_b32 v29, v24, v12
    v_and_b32 v30, v25, v11
    v_and_b32 v31, v25, v12
    v_and_b32 v32, v26, v11
    v_and_b32 v33, v26, v12
    v_and_b32 v34, v27, v11
    v_and_b32 v35, v27, v12
    v_mfma_f32_16x16x16_bf16 v[36:39], v[28:29], v[88:89], v[36:39]
    v_mfma_f32_16x16x16_bf16 v[40:43], v[28:29], v[90:91], v[40:43]
    v_mfma_f32_16x16x16_bf16 v[36:39], v[30:31], v[92:93], v[36:39]
    v_mfma_f32_16x16x16_bf16 v[40:43], v[30:31], v[94:95], v[40:43]
    v_mfma_f32_16x16x16_bf16 v[36:39], v[32:33], v[96:97], v[36:39]
    v_mfma_f32_16x16x16_bf16 v[40:43], v[32:33], v[98:99], v[40:43]
    v_mfma_f32_16x16x32_bf16 v[44:47], v[28:31], v[48:51], v[44:47]
    v_mfma_f32_16x16x32_bf16 v[44:47], v[32:35], v[48:51], v[44:47]
    s_mov_b64 exec, 1
    ds_max_u32 v186, v188 offset:8
    s_mov_b64 exec, -1
    v_add_u32 v188, 1, v188
L_w14:
    s_cbranch_execz L_w15
    s_waitcnt vmcnt(7)
    buffer_load_dwordx4 v4, s[16:19], s58 offen offset:3072 nt lds
    v_mfma_f32_16x16x16_bf16 v[36:39], v[34:35], v[100:101], v[36:39]
    v_mfma_f32_16x16x16_bf16 v[40:43], v[34:35], v[102:103], v[40:43]
    s_mov_b32 s22, s18
    s_waitcnt vmcnt(7)
    buffer_load_dwordx4 v[152:155], v9, s[20:23], s58 offen offset:0 nt
    ds_read_b128 v[24:27], v86 offset:2304
    s_waitcnt vmcnt(7)
    buffer_load_dwordx4 v[156:159], v9, s[20:23], s58 offen offset:1024 nt
    s_waitcnt lgkmcnt(0)
    v_fma_f32 v24, v24, s43, -v14
    v_fma_f32 v25, v25, s43, -v14
    v_fma_f32 v26, v26, s43, -v14
    v_fma_f32 v27, v27, s43, -v14
    v_exp_f32 v24, v24
    v_exp_f32 v25, v25
    v_exp_f32 v26, v26
    v_exp_f32 v27, v27
    s_waitcnt vmcnt(7)
    buffer_load_dwordx4 v[160:163], v9, s[20:23], s58 offen offset:2048 nt
    v_cvt_pk_bf16_f32 v24, v24, v24
    v_cvt_pk_bf16_f32 v25, v25, v25
    v_cvt_pk_bf16_f32 v26, v26, v26
    v_cvt_pk_bf16_f32 v27, v27, v27
    v_and_b32 v28, v24, v11
    v_and_b32 v29, v24, v12
    v_and_b32 v30, v25, v11
    v_and_b32 v31, v25, v12
    v_and_b32 v32, v26, v11
    v_and_b32 v33, v26, v12
    v_and_b32 v34, v27, v11
    v_and_b32 v35, v27, v12
    v_mfma_f32_16x16x16_bf16 v[36:39], v[28:29], v[104:105], v[36:39]
    v_mfma_f32_16x16x16_bf16 v[40:43], v[28:29], v[106:107], v[40:43]
    v_mfma_f32_16x16x16_bf16 v[36:39], v[30:31], v[108:109], v[36:39]
    v_mfma_f32_16x16x16_bf16 v[40:43], v[30:31], v[110:111], v[40:43]
    v_mfma_f32_16x16x16_bf16 v[36:39], v[32:33], v[112:113], v[36:39]
    v_mfma_f32_16x16x16_bf16 v[40:43], v[32:33], v[114:115], v[40:43]
    v_mfma_f32_16x16x32_bf16 v[44:47], v[28:31], v[48:51], v[44:47]
    v_mfma_f32_16x16x32_bf16 v[44:47], v[32:35], v[48:51], v[44:47]
L_w15:
    s_cbranch_execz L_w16
    s_waitcnt vmcnt(7)
    buffer_load_dwordx4 v[164:167], v9, s[20:23], s58 offen offset:3072 nt
    v_mfma_f32_16x16x16_bf16 v[36:39], v[34:35], v[116:117], v[36:39]
    v_mfma_f32_16x16x16_bf16 v[40:43], v[34:35], v[118:119], v[40:43]
L_loopB:
    s_cmp_ge_u32 s58, 0x200000
    s_cbranch_scc1 L_fin
L_qspin2:
    ds_read_b32 v189, v187
    s_waitcnt lgkmcnt(0)
    v_readfirstlane_b32 s59, v189
    s_add_u32 m0, s47, 4096
    s_cmp_eq_u32 s59, -1
    s_cbranch_scc1 L_qspin2
    s_cmp_lt_u32 s59, 0x200000
    s_cselect_b32 s18, 0x200000, 0
    v_add_u32 v187, 4, v187
    s_waitcnt vmcnt(7)
    buffer_load_dwordx4 v1, s[16:19], s59 offen offset:0 nt lds
    s_waitcnt vmcnt(7)
    buffer_load_dwordx4 v2, s[16:19], s59 offen offset:1024 nt lds
    s_waitcnt vmcnt(7)
    buffer_load_dwordx4 v3, s[16:19], s59 offen offset:2048 nt lds
    s_mov_b64 exec, 1
    ds_max_u32 v186, v188 offset:8
    s_mov_b64 exec, -1
    v_add_u32 v188, 1, v188
    s_waitcnt vmcnt(7)
    buffer_load_dwordx4 v4, s[16:19], s59 offen offset:3072 nt lds
    ds_read_b128 v[68:71], v5 offset:0
    ds_read_b128 v[72:75], v6 offset:0
    ds_read_b128 v[76:79], v7 offset:0
    ds_read_b128 v[80:83], v8 offset:0
    s_mov_b32 s22, s18
    s_waitcnt vmcnt(7)
    buffer_load_dwordx4 v[168:171], v9, s[20:23], s59 offen offset:0 nt
    s_waitcnt lgkmcnt(3)
    v_mfma_f32_16x16x32_bf16 v[20:23], v[68:71], v[52:55], 0
    s_waitcnt lgkmcnt(2)
    v_mfma_f32_16x16x32_bf16 v[20:23], v[72:75], v[56:59], v[20:23]
    s_waitcnt lgkmcnt(1)
    v_mfma_f32_16x16x32_bf16 v[20:23], v[76:79], v[60:63], v[20:23]
    s_waitcnt lgkmcnt(0)
    v_mfma_f32_16x16x32_bf16 v[20:23], v[80:83], v[64:67], v[20:23]
L_w16:
    s_cbranch_execz L_w17
    s_waitcnt vmcnt(7)
    buffer_load_dwordx4 v[172:175], v9, s[20:23], s59 offen offset:1024 nt
    s_nop 5
    v_max3_f32 v16, v20, v21, v22
    v_max_f32 v16, v16, v23
    v_cmp_gt_f32 vcc, v16, v13
    s_cbranch_vccnz L_newmax0
L_back0:
    v_fma_f32 v24, v20, s43, -v14
    v_fma_f32 v25, v21, s43, -v14
    v_fma_f32 v26, v22, s43, -v14
    v_fma_f32 v27, v23, s43, -v14
    v_exp_f32 v24, v24
    v_exp_f32 v25, v25
    v_exp_f32 v26, v26
    v_exp_f32 v27, v27
    s_waitcnt vmcnt(7)
    buffer_load_dwordx4 v[176:179], v9, s[20:23], s59 offen offset:2048 nt
    v_cvt_pk_bf16_f32 v24, v24, v24
    v_cvt_pk_bf16_f32 v25, v25, v25
    v_cvt_pk_bf16_f32 v26, v26, v26
    v_cvt_pk_bf16_f32 v27, v27, v27
    v_and_b32 v28, v24, v11
    v_and_b32 v29, v24, v12
    v_and_b32 v30, v25, v11
    v_and_b32 v31, v25, v12
    v_and_b32 v32, v26, v11
    v_and_b32 v33, v26, v12
    v_and_b32 v34, v27, v11
    v_and_b32 v35, v27, v12
    v_mfma_f32_16x16x16_bf16 v[36:39], v[28:29], v[152:153], v[36:39]
    v_mfma_f32_16x16x16_bf16 v[40:43], v[28:29], v[154:155], v[40:43]
    v_mfma_f32_16x16x16_bf16 v[36:39], v[30:31], v[156:157], v[36:39]
    v_mfma_f32_16x16x16_bf16 v[40:43], v[30:31], v[158:159], v[40:43]
    v_mfma_f32_16x16x16_bf16 v[36:39], v[32:33], v[160:161], v[36:39]
    v_mfma_f32_16x16x16_bf16 v[40:43], v[32:33], v[162:163], v[40:43]
    v_mfma_f32_16x16x32_bf16 v[44:47], v[28:31], v[48:51], v[44:47]
    v_mfma_f32_16x16x32_bf16 v[44:47], v[32:35], v[48:51], v[44:47]
    s_waitcnt vmcnt(7)
    buffer_load_dwordx4 v[180:183], v9, s[20:23], s59 offen offset:3072 nt
    v_mfma_f32_16x16x16_bf16 v[36:39], v[34:35], v[164:165], v[36:39]
    v_mfma_f32_16x16x16_bf16 v[40:43], v[34:35], v[166:167], v[40:43]
    s_cmp_ge_u32 s59, 0x200000
    s_cbranch_scc1 L_fin
L_qspin3:
    ds_read_b32 v189, v187
L_w17:
    s_cbranch_execz L_w18
    s_waitcnt lgkmcnt(0)
    v_readfirstlane_b32 s58, v189
    s_add_u32 m0, s47, 0
    s_cmp_eq_u32 s58, -1
    s_cbranch_scc1 L_qspin3
    s_cmp_lt_u32 s58, 0x200000
    s_cselect_b32 s18, 0x200000, 0
    v_add_u32 v187, 4, v187
    s_waitcnt vmcnt(7)
    buffer_load_dwordx4 v1, s[16:19], s58 offen offset:0 nt lds
    s_waitcnt vmcnt(7)
    buffer_load_dwordx4 v2, s[16:19], s58 offen offset:1024 nt lds
    s_waitcnt vmcnt(7)
    buffer_load_dwordx4 v3, s[16:19], s58 offen offset:2048 nt lds
    s_mov_b64 exec, 1
    ds_max_u32 v186, v188 offset:8
    s_mov_b64 exec, -1
    v_add_u32 v188, 1, v188
    s_waitcnt vmcnt(7)
    buffer_load_dwordx4 v4, s[16:19], s58 offen offset:3072 nt lds
    ds_read_b128 v[68:71], v5 offset:4096
    ds_read_b128 v[72:75], v6 offset:4096
    ds_read_b128 v[76:79], v7 offset:4096
    ds_read_b128 v[80:83], v8 offset:4096
    s_mov_b32 s22, s18
    s_waitcnt vmcnt(7)
    buffer_load_dwordx4 v[152:155], v9, s[20:23], s58 offen offset:0 nt
    s_waitcnt lgkmcnt(3)
    v_mfma_f32_16x16x32_bf16 v[20:23], v[68:71], v[52:55], 0
    s_waitcnt lgkmcnt(2)
    v_mfma_f32_16x16x32_bf16 v[20:23], v[72:75], v[56:59], v[20:23]
    s_waitcnt lgkmcnt(1)
    v_mfma_f32_16x16x32_bf16 v[20:23], v[76:79], v[60:63], v[20:23]
    s_waitcnt lgkmcnt(0)
    v_mfma_f32_16x16x32_bf16 v[20:23], v[80:83], v[64:67], v[20:23]
    s_waitcnt vmcnt(7)
    buffer_load_dwordx4 v[156:159], v9, s[20:23], s58 offen offset:1024 nt
    s_nop 5
    v_max3_f32 v16, v20, v21, v22
    v_max_f32 v16, v16, v23
    v_cmp_gt_f32 vcc, v16, v13
    s_cbranch_vccnz L_newmax1
L_back1:
    v_fma_f32 v24, v20, s43, -v14
    v_fma_f32 v25, v21, s43, -v14
    v_fma_f32 v26, v22, s43, -v14
    v_fma_f32 v27, v23, s43, -v14
    v_exp_f32 v24, v24
    v_exp_f32 v25, v25
    v_exp_f32 v26, v26
    v_exp_f32 v27, v27
L_w18:
    s_cbranch_execz L_w19
    s_waitcnt vmcnt(7)
    buffer_load_dwordx4 v[160:163], v9, s[20:23], s58 offen offset:2048 nt
    v_cvt_pk_bf16_f32 v24, v24, v24
    v_cvt_pk_bf16_f32 v25, v25, v25
    v_cvt_pk_bf16_f32 v26, v26, v26
    v_cvt_pk_bf16_f32 v27, v27, v27
    v_and_b32 v28, v24, v11
    v_and_b32 v29, v24, v12
    v_and_b32 v30, v25, v11
    v_and_b32 v31, v25, v12
    v_and_b32 v32, v26, v11
    v_and_b32 v33, v26, v12
    v_and_b32 v34, v27, v11
    v_and_b32 v35, v27, v12
    v_mfma_f32_16x16x16_bf16 v[36:39], v[28:29], v[168:169], v[36:39]
    v_mfma_f32_16x16x16_bf16 v[40:43], v[28:29], v[170:171], v[40:43]
    v_mfma_f32_16x16x16_bf16 v[36:39], v[30:31], v[172:173], v[36:39]
    v_mfma_f32_16x16x16_bf16 v[40:43], v[30:31], v[174:175], v[40:43]
    v_mfma_f32_16x16x16_bf16 v[36:39], v[32:33], v[176:177], v[36:39]
    v_mfma_f32_16x16x16_bf16 v[40:43], v[32:33], v[178:179], v[40:43]
    v_mfma_f32_16x16x32_bf16 v[44:47], v[28:31], v[48:51], v[44:47]
    v_mfma_f32_16x16x32_bf16 v[44:47], v[32:35], v[48:51], v[44:47]
    s_waitcnt vmcnt(7)
    buffer_load_dwordx4 v[164:167], v9, s[20:23], s58 offen offset:3072 nt
    v_mfma_f32_16x16x16_bf16 v[36:39], v[34:35], v[180:181], v[36:39]
    v_mfma_f32_16x16x16_bf16 v[40:43], v[34:35], v[182:183], v[40:43]
    s_branch L_loopB
L_newmax0:
    v_max_f32 v13, v16, v13
    v_mov_b32 v17, v13
    s_nop 1
    v_permlane16_swap_b32 v13, v17
    s_nop 0
    v_max_f32 v13, v13, v17
    v_mov_b32 v17, v13
    s_nop 1
    v_permlane32_swap_b32 v13, v17
    s_nop 0
    v_max_f32 v13, v13, v17
    v_mul_f32 v16, s43, v13
    v_sub_f32 v15, v14, v16
    v_exp_f32 v15, v15
    v_mov_b32 v14, v16
    s_nop 1
    v_mul_f32_dpp v36, v15, v36 quad_perm:[0,0,0,0] row_mask:0xf bank_mask:0xf
    v_mul_f32_dpp v37, v15, v37 quad_perm:[1,1,1,1] row_mask:0xf bank_mask:0xf
    v_mul_f32_dpp v38, v15, v38 quad_perm:[2,2,2,2] row_mask:0xf bank_mask:0xf
    v_mul_f32_dpp v39, v15, v39 quad_perm:[3,3,3,3] row_mask:0xf bank_mask:0xf
    v_mul_f32_dpp v40, v15, v40 quad_perm:[0,0,0,0] row_mask:0xf bank_mask:0xf
    v_mul_f32_dpp v41, v15, v41 quad_perm:[1,1,1,1] row_mask:0xf bank_mask:0xf
    v_mul_f32_dpp v42, v15, v42 quad_perm:[2,2,2,2] row_mask:0xf bank_mask:0xf
    v_mul_f32_dpp v43, v15, v43 quad_perm:[3,3,3,3] row_mask:0xf bank_mask:0xf
    v_mul_f32_dpp v44, v15, v44 quad_perm:[0,0,0,0] row_mask:0xf bank_mask:0xf
    v_mul_f32_dpp v45, v15, v45 quad_perm:[1,1,1,1] row_mask:0xf bank_mask:0xf
    v_mul_f32_dpp v46, v15, v46 quad_perm:[2,2,2,2] row_mask:0xf bank_mask:0xf
    v_mul_f32_dpp v47, v15, v47 quad_perm:[3,3,3,3] row_mask:0xf bank_mask:0xf
    s_branch L_back0
L_newmax1:
    v_max_f32 v13, v16, v13
    v_mov_b32 v17, v13
    s_nop 1
    v_permlane16_swap_b32 v13, v17
    s_nop 0
    v_max_f32 v13, v13, v17
    v_mov_b32 v17, v13
    s_nop 1
    v_permlane32_swap_b32 v13, v17
    s_nop 0
    v_max_f32 v13, v13, v17
    v_mul_f32 v16, s43, v13
    v_sub_f32 v15, v14, v16
    v_exp_f32 v15, v15
    v_mov_b32 v14, v16
    s_nop 1
    v_mul_f32_dpp v36, v15, v36 quad_perm:[0,0,0,0] row_mask:0xf bank_mask:0xf
    v_mul_f32_dpp v37, v15, v37 quad_perm:[1,1,1,1] row_mask:0xf bank_mask:0xf
    v_mul_f32_dpp v38, v15, v38 quad_perm:[2,2,2,2] row_mask:0xf bank_mask:0xf
    v_mul_f32_dpp v39, v15, v39 quad_perm:[3,3,3,3] row_mask:0xf bank_mask:0xf
    v_mul_f32_dpp v40, v15, v40 quad_perm:[0,0,0,0] row_mask:0xf bank_mask:0xf
    v_mul_f32_dpp v41, v15, v41 quad_perm:[1,1,1,1] row_mask:0xf bank_mask:0xf
    v_mul_f32_dpp v42, v15, v42 quad_perm:[2,2,2,2] row_mask:0xf bank_mask:0xf
    v_mul_f32_dpp v43, v15, v43 quad_perm:[3,3,3,3] row_mask:0xf bank_mask:0xf
    v_mul_f32_dpp v44, v15, v44 quad_perm:[0,0,0,0] row_mask:0xf bank_mask:0xf
    v_mul_f32_dpp v45, v15, v45 quad_perm:[1,1,1,1] row_mask:0xf bank_mask:0xf
    v_mul_f32_dpp v46, v15, v46 quad_perm:[2,2,2,2] row_mask:0xf bank_mask:0xf
    v_mul_f32_dpp v47, v15, v47 quad_perm:[3,3,3,3] row_mask:0xf bank_mask:0xf
    s_branch L_back1
L_fin:
L_w19:
    s_cbranch_execz L_w20
    v_mov_b32 v24, 1
    ds_write_b32 v10, v14 offset:512
    s_nop 3
    ds_write_b128 v18, v[36:39]
    ds_write_b128 v18, v[40:43] offset:1024
    s_mov_b64 exec, 1
    ds_write_b128 v10, v[44:47] offset:528
    ds_add_rtn_u32 v24, v186, v24 offset:12
    ds_read_b32 v22, v186 offset:0
    s_waitcnt lgkmcnt(0)
    v_readfirstlane_b32 s45, v24
    v_readfirstlane_b32 s54, v22
    s_nop 0
    s_cmp_lg_u32 s45, 3
    s_cbranch_scc1 L_done
    buffer_atomic_add v184, off, s[36:39], 0 sc0
    s_mov_b64 exec, -1
    ds_read2_b32 v[20:21], v85 offset0:128 offset1:132
    ds_read_b128 v[52:55], v19 offset:1024
    ds_read_b128 v[56:59], v19 offset:2048
    ds_read_b128 v[60:63], v19 offset:3072
    ds_read_b128 v[64:67], v19 offset:4096
    ds_read_b128 v[68:71], v19 offset:5120
    ds_read_b128 v[72:75], v19 offset:6144
    ds_read_b128 v[76:79], v19 offset:7168
    ds_read_b128 v[80:83], v19 offset:8192
    buffer_load_dwordx4 v[88:91], v19, s[28:31], s51 offen offset:0 sc1
    buffer_load_dwordx4 v[92:95], v19, s[28:31], s51 offen offset:1024 sc1
    buffer_load_dwordx4 v[96:99], v19, s[28:31], s51 offen offset:2048 sc1
    buffer_load_dwordx4 v[100:103], v19, s[28:31], s52 offen offset:0 sc1
    buffer_load_dwordx4 v[104:107], v19, s[28:31], s52 offen offset:1024 sc1
    buffer_load_dwordx4 v[108:111], v19, s[28:31], s52 offen offset:2048 sc1
    buffer_load_dwordx4 v[112:115], v19, s[28:31], s53 offen offset:0 sc1
    buffer_load_dwordx4 v[116:119], v19, s[28:31], s53 offen offset:1024 sc1
    buffer_load_dwordx4 v[120:123], v19, s[28:31], s53 offen offset:2048 sc1
    s_xor_b32 s57, s54, 0x2c5397a6
    s_waitcnt lgkmcnt(8)
    v_max_f32_dpp v190, v20, v20 row_ror:4 row_mask:0xf bank_mask:0xf
    s_nop 1
    v_max_f32_dpp v190, v190, v190 row_ror:8 row_mask:0xf bank_mask:0xf
    v_sub_f32 v15, v20, v190
    v_exp_f32 v15, v15
    s_nop 0
    v_mul_f32 v191, v15, v21
    s_nop 1
    v_add_f32_dpp v191, v191, v191 row_ror:4 row_mask:0xf bank_mask:0xf
    s_nop 1
    v_add_f32_dpp v191, v191, v191 row_ror:8 row_mask:0xf bank_mask:0xf
    v_bitop3_b32 v192, v190, s57, v191 bitop3:0x96
L_w20:
    s_cbranch_execz L_w21
    s_waitcnt lgkmcnt(0)
    v_mul_f32_dpp v36, v15, v52 row_newbcast:0 row_mask:0xf bank_mask:0xf
    v_mul_f32_dpp v37, v15, v53 row_newbcast:1 row_mask:0xf bank_mask:0xf
    v_mul_f32_dpp v38, v15, v54 row_newbcast:2 row_mask:0xf bank_mask:0xf
    v_mul_f32_dpp v39, v15, v55 row_newbcast:3 row_mask:0xf bank_mask:0xf
    v_mul_f32_dpp v40, v15, v56 row_newbcast:0 row_mask:0xf bank_mask:0xf
    v_mul_f32_dpp v41, v15, v57 row_newbcast:1 row_mask:0xf bank_mask:0xf
    v_mul_f32_dpp v42, v15, v58 row_newbcast:2 row_mask:0xf bank_mask:0xf
    v_mul_f32_dpp v43, v15, v59 row_newbcast:3 row_mask:0xf bank_mask:0xf
    v_fmac_f32_dpp v36, v15, v60 row_newbcast:4 row_mask:0xf bank_mask:0xf
    v_fmac_f32_dpp v37, v15, v61 row_newbcast:5 row_mask:0xf bank_mask:0xf
    v_fmac_f32_dpp v38, v15, v62 row_newbcast:6 row_mask:0xf bank_mask:0xf
    v_fmac_f32_dpp v39, v15, v63 row_newbcast:7 row_mask:0xf bank_mask:0xf
    v_fmac_f32_dpp v40, v15, v64 row_newbcast:4 row_mask:0xf bank_mask:0xf
    v_fmac_f32_dpp v41, v15, v65 row_newbcast:5 row_mask:0xf bank_mask:0xf
    v_fmac_f32_dpp v42, v15, v66 row_newbcast:6 row_mask:0xf bank_mask:0xf
    v_fmac_f32_dpp v43, v15, v67 row_newbcast:7 row_mask:0xf bank_mask:0xf
L_w21:
    s_cbranch_execz L_w22
    v_fmac_f32_dpp v36, v15, v68 row_newbcast:8 row_mask:0xf bank_mask:0xf
    v_fmac_f32_dpp v37, v15, v69 row_newbcast:9 row_mask:0xf bank_mask:0xf
    v_fmac_f32_dpp v38, v15, v70 row_newbcast:10 row_mask:0xf bank_mask:0xf
    v_fmac_f32_dpp v39, v15, v71 row_newbcast:11 row_mask:0xf bank_mask:0xf
    v_fmac_f32_dpp v40, v15, v72 row_newbcast:8 row_mask:0xf bank_mask:0xf
    v_fmac_f32_dpp v41, v15, v73 row_newbcast:9 row_mask:0xf bank_mask:0xf
    v_fmac_f32_dpp v42, v15, v74 row_newbcast:10 row_mask:0xf bank_mask:0xf
    v_fmac_f32_dpp v43, v15, v75 row_newbcast:11 row_mask:0xf bank_mask:0xf
    v_fmac_f32_dpp v36, v15, v76 row_newbcast:12 row_mask:0xf bank_mask:0xf
    v_fmac_f32_dpp v37, v15, v77 row_newbcast:13 row_mask:0xf bank_mask:0xf
    v_fmac_f32_dpp v38, v15, v78 row_newbcast:14 row_mask:0xf bank_mask:0xf
    v_fmac_f32_dpp v39, v15, v79 row_newbcast:15 row_mask:0xf bank_mask:0xf
    v_fmac_f32_dpp v40, v15, v80 row_newbcast:12 row_mask:0xf bank_mask:0xf
    v_fmac_f32_dpp v41, v15, v81 row_newbcast:13 row_mask:0xf bank_mask:0xf
    v_fmac_f32_dpp v42, v15, v82 row_newbcast:14 row_mask:0xf bank_mask:0xf
    v_fmac_f32_dpp v43, v15, v83 row_newbcast:15 row_mask:0xf bank_mask:0xf
    s_waitcnt vmcnt(9)
    v_readfirstlane_b32 s45, v184
    s_mov_b32 vcc_lo, 0x000f000f
    s_sub_u32 s45, s45, s54
    s_bfe_u32 s45, s45, 0x80010
    s_mov_b32 vcc_hi, 0x000f000f
    s_cmp_eq_u32 s45, 3
    s_cbranch_scc1 L_last
    buffer_store_dwordx4 v[36:39], v19, s[28:31], s50 offen sc1
    buffer_store_dwordx4 v[40:43], v19, s[28:31], s50 offen offset:1024 sc1
    v_bitop3_b32 v192, v192, v36, v37 bitop3:0x96
    v_bitop3_b32 v192, v192, v38, v39 bitop3:0x96
    v_bitop3_b32 v192, v192, v40, v41 bitop3:0x96
    v_bitop3_b32 v192, v192, v42, v43 bitop3:0x96
    buffer_store_dwordx4 v[190:193], v19, s[28:31], s50 offen offset:2048 sc1
    s_branch L_st
L_last:
    s_waitcnt vmcnt(0)
    s_branch L_check
L_retry:
    s_mov_b32 vcc_lo, 0x000f000f
    s_mov_b32 vcc_hi, 0x000f000f
    buffer_load_dwordx4 v[88:91], v19, s[28:31], s51 offen offset:0 sc1
    buffer_load_dwordx4 v[92:95], v19, s[28:31], s51 offen offset:1024 sc1
    buffer_load_dwordx4 v[96:99], v19, s[28:31], s51 offen offset:2048 sc1
    buffer_load_dwordx4 v[100:103], v19, s[28:31], s52 offen offset:0 sc1
    buffer_load_dwordx4 v[104:107], v19, s[28:31], s52 offen offset:1024 sc1
    buffer_load_dwordx4 v[108:111], v19, s[28:31], s52 offen offset:2048 sc1
    buffer_load_dwordx4 v[112:115], v19, s[28:31], s53 offen offset:0 sc1
    buffer_load_dwordx4 v[116:119], v19, s[28:31], s53 offen offset:1024 sc1
    buffer_load_dwordx4 v[120:123], v19, s[28:31], s53 offen offset:2048 sc1
L_w22:
    s_cbranch_execz L_w23
    s_waitcnt vmcnt(0)
L_check:
L_w23:
    s_cbranch_execz L_w24
    v_mov_b32 v20, v190
    v_mov_b32 v21, v191
    v_bitop3_b32 v24, v88, s57, v89 bitop3:0x96
    v_bitop3_b32 v25, v100, s57, v101 bitop3:0x96
    v_bitop3_b32 v26, v112, s57, v113 bitop3:0x96
    v_mov_b32_dpp v20, v96 quad_perm:[0,1,2,3] row_mask:0xf bank_mask:0x2
    v_mov_b32_dpp v21, v97 quad_perm:[0,1,2,3] row_mask:0xf bank_mask:0x2
    v_bitop3_b32 v24, v24, v90, v91 bitop3:0x96
    v_bitop3_b32 v24, v24, v92, v93 bitop3:0x96
    v_bitop3_b32 v24, v24, v94, v95 bitop3:0x96
    v_bitop3_b32 v24, v24, v96, v97 bitop3:0x96
    v_xor_b32 v24, v24, v98
    v_mov_b32_dpp v20, v108 quad_perm:[0,1,2,3] row_mask:0xf bank_mask:0x4
    v_mov_b32_dpp v21, v109 quad_perm:[0,1,2,3] row_mask:0xf bank_mask:0x4
    v_bitop3_b32 v25, v25, v102, v103 bitop3:0x96
    v_bitop3_b32 v25, v25, v104, v105 bitop3:0x96
    v_bitop3_b32 v25, v25, v106, v107 bitop3:0x96
    v_bitop3_b32 v25, v25, v108, v109 bitop3:0x96
    v_xor_b32 v25, v25, v110
    v_mov_b32_dpp v20, v120 quad_perm:[0,1,2,3] row_mask:0xf bank_mask:0x8
    v_mov_b32_dpp v21, v121 quad_perm:[0,1,2,3] row_mask:0xf bank_mask:0x8
    v_bitop3_b32 v26, v26, v114, v115 bitop3:0x96
    v_bitop3_b32 v26, v26, v116, v117 bitop3:0x96
    v_bitop3_b32 v26, v26, v118, v119 bitop3:0x96
    v_bitop3_b32 v26, v26, v120, v121 bitop3:0x96
    v_xor_b32 v26, v26, v122
    v_or3_b32 v24, v24, v25, v26
    v_cmp_ne_u32 vcc, 0, v24
    s_cbranch_vccnz L_retry
    v_max_f32_dpp v22, v20, v20 row_ror:4 row_mask:0xf bank_mask:0xf
    s_nop 1
    v_max_f32_dpp v22, v22, v22 row_ror:8 row_mask:0xf bank_mask:0xf
    v_sub_f32 v15, v20, v22
    v_exp_f32 v15, v15
    s_nop 0
    v_mul_f32 v23, v15, v21
    s_nop 1
    v_add_f32_dpp v23, v23, v23 row_ror:4 row_mask:0xf bank_mask:0xf
    s_nop 1
    v_add_f32_dpp v23, v23, v23 row_ror:8 row_mask:0xf bank_mask:0xf
    v_rcp_f32 v23, v23
    s_mov_b32 s44, 0x05040100
    v_mul_f32 v15, v15, v23
    s_mov_b32 s45, 0x07060302
    s_nop 0
    v_mul_f32_dpp v36, v15, v36 row_newbcast:0 row_mask:0xf bank_mask:0xf
    v_mul_f32_dpp v37, v15, v37 row_newbcast:1 row_mask:0xf bank_mask:0xf
    v_mul_f32_dpp v38, v15, v38 row_newbcast:2 row_mask:0xf bank_mask:0xf
    v_mul_f32_dpp v39, v15, v39 row_newbcast:3 row_mask:0xf bank_mask:0xf
    v_mul_f32_dpp v40, v15, v40 row_newbcast:0 row_mask:0xf bank_mask:0xf
    v_mul_f32_dpp v41, v15, v41 row_newbcast:1 row_mask:0xf bank_mask:0xf
    v_mul_f32_dpp v42, v15, v42 row_newbcast:2 row_mask:0xf bank_mask:0xf
    v_mul_f32_dpp v43, v15, v43 row_newbcast:3 row_mask:0xf bank_mask:0xf
    v_fmac_f32_dpp v36, v15, v88 row_newbcast:4 row_mask:0xf bank_mask:0xf
    v_fmac_f32_dpp v37, v15, v89 row_newbcast:5 row_mask:0xf bank_mask:0xf
    v_fmac_f32_dpp v38, v15, v90 row_newbcast:6 row_mask:0xf bank_mask:0xf
    v_fmac_f32_dpp v39, v15, v91 row_newbcast:7 row_mask:0xf bank_mask:0xf
    v_fmac_f32_dpp v40, v15, v92 row_newbcast:4 row_mask:0xf bank_mask:0xf
    v_fmac_f32_dpp v41, v15, v93 row_newbcast:5 row_mask:0xf bank_mask:0xf
    v_fmac_f32_dpp v42, v15, v94 row_newbcast:6 row_mask:0xf bank_mask:0xf
    v_fmac_f32_dpp v43, v15, v95 row_newbcast:7 row_mask:0xf bank_mask:0xf
L_w24:
    s_cbranch_execz L_w25
    v_fmac_f32_dpp v36, v15, v100 row_newbcast:8 row_mask:0xf bank_mask:0xf
    v_fmac_f32_dpp v37, v15, v101 row_newbcast:9 row_mask:0xf bank_mask:0xf
    v_fmac_f32_dpp v38, v15, v102 row_newbcast:10 row_mask:0xf bank_mask:0xf
    v_fmac_f32_dpp v39, v15, v103 row_newbcast:11 row_mask:0xf bank_mask:0xf
    v_fmac_f32_dpp v40, v15, v104 row_newbcast:8 row_mask:0xf bank_mask:0xf
    v_fmac_f32_dpp v41, v15, v105 row_newbcast:9 row_mask:0xf bank_mask:0xf
    v_fmac_f32_dpp v42, v15, v106 row_newbcast:10 row_mask:0xf bank_mask:0xf
    v_fmac_f32_dpp v43, v15, v107 row_newbcast:11 row_mask:0xf bank_mask:0xf
    v_fmac_f32_dpp v36, v15, v112 row_newbcast:12 row_mask:0xf bank_mask:0xf
    v_fmac_f32_dpp v37, v15, v113 row_newbcast:13 row_mask:0xf bank_mask:0xf
    v_fmac_f32_dpp v38, v15, v114 row_newbcast:14 row_mask:0xf bank_mask:0xf
    v_fmac_f32_dpp v39, v15, v115 row_newbcast:15 row_mask:0xf bank_mask:0xf
    v_fmac_f32_dpp v40, v15, v116 row_newbcast:12 row_mask:0xf bank_mask:0xf
    v_fmac_f32_dpp v41, v15, v117 row_newbcast:13 row_mask:0xf bank_mask:0xf
    v_fmac_f32_dpp v42, v15, v118 row_newbcast:14 row_mask:0xf bank_mask:0xf
    v_fmac_f32_dpp v43, v15, v119 row_newbcast:15 row_mask:0xf bank_mask:0xf
    v_cvt_pk_bf16_f32 v28, v36, v40
    v_cvt_pk_bf16_f32 v29, v37, v41
    v_cvt_pk_bf16_f32 v30, v38, v42
    v_cvt_pk_bf16_f32 v31, v39, v43
    s_nop 0
    v_permlane32_swap_b32 v28, v30
    v_permlane32_swap_b32 v29, v31
    s_nop 1
    v_permlane16_swap_b32 v28, v29
    v_permlane16_swap_b32 v30, v31
    s_nop 0
    v_perm_b32 v32, v29, v28, s44
    v_perm_b32 v33, v31, v30, s44
    v_perm_b32 v34, v29, v28, s45
    v_perm_b32 v35, v31, v30, s45
    buffer_store_dwordx4 v[32:35], v19, s[32:35], 0 offen
L_st:
L_done:
    s_endpgm
L_helper:
    v_mov_b32 v16, 0
    v_mov_b32 v21, 0
    s_waitcnt lgkmcnt(0)
    s_add_u32 s36, s14, s55
    s_addc_u32 s37, s15, 0
    s_add_u32 s36, s36, 16384
    s_addc_u32 s37, s37, 0
    s_mov_b32 s38, 4
    s_mov_b32 s39, 0x00020000
    s_mov_b32 s28, s12
    s_mov_b32 s29, s13
    s_mov_b32 s30, 256
    s_mov_b32 s31, 0x00020000
    s_mov_b64 exec, 1
    s_lshl_b32 s44, s40, 2
    v_mov_b32 v17, 16
    s_mov_b32 s46, 3
    s_cmp_eq_u32 s41, 0
    s_cbranch_scc1 L_publish
L_warm:
    s_mov_b64 exec, 0
    s_branch L_w0
L_w25:
    s_mov_b64 exec, 1
    s_cmp_eq_u32 s41, 0
    s_cbranch_scc1 L_napB
L_napA:
    s_sleep 16
    ds_read_b32 v23, v16 offset:8
    s_waitcnt lgkmcnt(0)
    v_readfirstlane_b32 s55, v23
    s_nop 1
    s_cmp_lt_u32 s55, 1
    s_cbranch_scc1 L_napA
    buffer_load_dword v20, off, s[28:31], s44 sc1
    s_waitcnt vmcnt(0)
    v_cmp_ne_u32 vcc, 0, v20
    s_cbranch_vccnz L_havebase
L_publish:
    buffer_load_dword v20, off, s[36:39], 0 sc1
    s_waitcnt vmcnt(0)
    v_or_b32 v20, 0x80000000, v20
    v_mov_b32 v22, v20
    buffer_atomic_cmpswap v[20:21], off, s[28:31], s44 sc0
    s_waitcnt vmcnt(0)
    v_cmp_eq_u32 vcc, 0, v20
    s_nop 1
    v_cndmask_b32 v20, v20, v22, vcc
L_havebase:
    ds_write_b32 v16, v20 offset:0
    s_cmp_eq_u32 s41, 0
    s_cbranch_scc1 L_warm
L_napB:
    s_sleep 16
    ds_read_b32 v23, v16 offset:8
    s_waitcnt lgkmcnt(0)
    v_readfirstlane_b32 s55, v23
    s_nop 1
    s_cmp_lt_u32 s55, 2
    s_cbranch_scc1 L_napB
L_hloop:
    ds_read_b32 v21, v16 offset:8
    s_waitcnt lgkmcnt(0)
    v_readfirstlane_b32 s55, v21
    s_nop 1
    s_cmp_ge_u32 s55, s46
    s_cbranch_scc1 L_grab
    s_sleep 1
    s_branch L_hloop
L_grab:
    s_add_u32 s46, s46, 1
    v_mov_b32 v24, 1
    buffer_atomic_add v24, off, s[36:39], 0 sc0
    s_waitcnt vmcnt(0)
    v_sub_u32 v24, v24, v20
    v_and_b32 v24, 0xffff, v24
    v_add_u32 v25, 120, v24
    v_lshlrev_b32 v25, 14, v25
    ds_write_b32 v17, v25
    v_readfirstlane_b32 s55, v24
    v_add_u32 v17, 4, v17
    s_nop 0
    s_cmp_lt_u32 s55, 7
    s_cbranch_scc1 L_hloop
    v_mov_b32 v25, 0x10000000
    ds_write_b32 v17, v25
    s_waitcnt lgkmcnt(0)
    s_endpgm
.section .rodata,"a"
.p2align 6
.amdhsa_kernel standalone__gqa_softmax__decode_kernel
  .amdhsa_next_free_vgpr 200
  .amdhsa_next_free_sgpr 96
  .amdhsa_accum_offset 200
  .amdhsa_group_segment_fixed_size 0
  .amdhsa_kernarg_size 48
  .amdhsa_user_sgpr_count 2
  .amdhsa_user_sgpr_kernarg_segment_ptr 1
  .amdhsa_system_sgpr_workgroup_id_x 1
.end_amdhsa_kernel
```
